```python
import torch

def _softmax(x, axis=-1):
    return torch.softmax(x, dim=axis)
def _gelu(x):
    return torch.nn.functional.gelu(x, approximate="tanh")
def _silu(x):
    return torch.nn.functional.silu(x)
def _sigmoid(x):
    return torch.sigmoid(x)
def _layernorm(x, axis=-1, eps=1e-5):
    m = x.mean(dim=axis, keepdim=True)
    v = x.var(dim=axis, keepdim=True, unbiased=False)
    return (x - m) / torch.sqrt(v + eps)
def _scatter_add(tgt, idx, src, axis=0):
    return tgt.clone().index_add_(axis, idx, src)
def _segment_sum(src, seg, n):
    out = torch.zeros((n,) + src.shape[1:], dtype=src.dtype)
    return out.index_add_(0, seg, src)
def _pad(x, pw):
    flat = tuple(v for pair in reversed(pw) for v in pair)
    return torch.nn.functional.pad(x, flat)

kernel_name = 'gated_mix__sliding_block_cached__dense_activation_gelu__decode'

def setup_inputs():

    _w = (lambda a: (lambda t: t.to(torch.bfloat16) if t.is_floating_point() else t)(torch.as_tensor(a)))
    def _A_setup():
        B, Sq, D = 1, 1, 512
        Hq, Hkv, Sk, Dh = 32, 8, 65536, 128
        assert Hq % Hkv == 0, (Hq, Hkv)
        return {
            "x": _w((lambda *s: torch.randn(*s, dtype=torch.bfloat16) * 0.05)(B, Sq, D)),
            "k_cache": _w((lambda *s: torch.randn(*s, dtype=torch.bfloat16) * 3.2)(B, Hkv, Sk, Dh)),
            "v_cache": _w((lambda *s: torch.randn(*s, dtype=torch.bfloat16) * 0.4)(B, Hkv, Sk, Dh)),
            "wq": _w((lambda *s: torch.randn(*s, dtype=torch.bfloat16) * 3.2)(D, Hq * Dh) * (D ** -0.5)),
            "wo": _w((lambda *s: torch.randn(*s, dtype=torch.bfloat16) * 0.4)(Hq * Dh, D) * ((Hq * Dh) ** -0.5)),
        }
    _A_in = _A_setup()

    def _B_setup():
        B, S, D, F = 1, 1, 512, 1792
        return {
            "x": _w((lambda *s: torch.randn(*s, dtype=torch.bfloat16) * 0.05)(B, S, D)),
            "w1": _w((lambda *s: torch.randn(*s, dtype=torch.bfloat16) * 0.2)(D, F) * (D ** -0.5)),
            "b1": _w((lambda *s: torch.randn(*s, dtype=torch.bfloat16) * 0.2)(F) * 0.01),
            "w2": _w((lambda *s: torch.randn(*s, dtype=torch.bfloat16) * 0.2)(F, D) * (F ** -0.5)),
            "b2": _w((lambda *s: torch.randn(*s, dtype=torch.bfloat16) * 0.05)(D) * 0.01),
        }
    _B_in = _B_setup()

    return {
        "A_x": _A_in["x"],
        "A_k_cache": _A_in["k_cache"],
        "A_v_cache": _A_in["v_cache"],
        "A_wq": _A_in["wq"],
        "A_wo": _A_in["wo"],
        "B_x": _B_in["x"],
        "B_w1": _B_in["w1"],
        "B_b1": _B_in["b1"],
        "B_w2": _B_in["w2"],
        "B_b2": _B_in["b2"],
        "gate_w": _w((lambda *s: torch.randn(*s, dtype=torch.bfloat16) * 0.1)(512) * 16.0),
    }

def reference(A_x, A_k_cache, A_v_cache, A_wq, A_wo, B_x, B_w1, B_b1, B_w2, B_b2, gate_w):
    def _A_ref(x, k_cache, v_cache, wq, wo):
        B, Sq, D = x.shape
        Hq, Dh = 32, 128
        Hkv, Sk = k_cache.shape[1], k_cache.shape[2]
        W = min(4096, max(256, Sk // 4))
        rep = Hq // Hkv
        q = (lambda x, *d: x.permute(*d))((x @ wq).reshape(B, Sq, Hq, Dh), 0, 2, 1, 3)
        k = (lambda x, n, axis: torch.repeat_interleave(x, n, dim=axis))(k_cache[:, :, Sk - W:, :], rep, axis=1)
        v = (lambda x, n, axis: torch.repeat_interleave(x, n, dim=axis))(v_cache[:, :, Sk - W:, :], rep, axis=1)
        scores = torch.einsum("bhqd,bhkd->bhqk", q, k) * (Dh ** -0.5)
        p = _softmax(scores, axis=-1)
        o = torch.einsum("bhqk,bhkd->bhqd", p, v)
        return (lambda x, *d: x.permute(*d))(o, 0, 2, 1, 3).reshape(B, Sq, Hq * Dh) @ wo

    def _B_ref(x, w1, b1, w2, b2):
        h = torch.einsum("bsd,df->bsf", x, w1) + b1
        h = _gelu(h)
        return torch.einsum("bsf,fd->bsd", h, w2) + b2

    x = A_x
    g = _sigmoid((x * gate_w).sum(-1, keepdims=True))
    a = _A_ref(x, A_k_cache, A_v_cache, A_wq, A_wo)
    b = _B_ref(x, B_w1, B_b1, B_w2, B_b2)
    return g * a + (1 - g) * b
```

```asm
; @launch grid=(256,1,1) block=(384,1,1) lds=11520
.amdgcn_target "amdgcn-amd-amdhsa--gfx950"
.text
.globl gated_mix__sliding_block_cached__dense_activation_gelu__decode_kernel
.p2align 8
.type gated_mix__sliding_block_cached__dense_activation_gelu__decode_kernel,@function
gated_mix__sliding_block_cached__dense_activation_gelu__decode_kernel:
  s_load_dwordx16 s[4:19], s[0:1], 0
  s_load_dwordx8 s[20:27], s[0:1], 64
  s_load_dwordx4 s[28:31], s[0:1], 96
  v_lshrrev_b32 v1, 6, v0
  v_and_b32 v2, 63, v0
  s_cmp_ge_u32 s2, 256
  v_readfirstlane_b32 s34, v1
  s_cbranch_scc1 Lend
  s_and_b32 s32, s2, 7
  s_lshr_b32 s33, s2, 3
  s_cmp_ge_u32 s34, 2
  s_cbranch_scc1 LA
  s_lshl_b32 s37, s32, 10
  s_lshr_b32 s38, s33, 2
  s_lshl_b32 s38, s38, 7
  s_add_u32 s37, s37, s38
  s_and_b32 s39, s33, 3
  s_lshl_b32 s38, s39, 20
  s_add_u32 s37, s37, s38
  s_lshl_b32 s39, s39, 8
  s_mul_i32 s38, s32, 458752
  s_lshl_b32 s40, s33, 7
  s_add_u32 s38, s38, s40
  s_lshl_b32 s40, s32, 8
  s_mov_b32 s52, 57344
  s_movk_i32 s55, 3584
  s_cmp_eq_u32 s34, 0
  s_cselect_b32 s37, s37, s38
  s_cselect_b32 s39, s39, s40
  s_cselect_b32 s52, 0x20000, s52
  s_cselect_b32 s55, 0x2000, s55
  v_lshrrev_b32 v4, 3, v2
  v_and_b32 v3, 7, v2
  v_mul_u32_u24 v5, s52, v4
  v_lshlrev_b32 v6, 4, v3
  v_add3_u32 v5, v5, v6, s37
  v_lshl_add_u32 v6, v4, 5, s39
  s_cbranch_scc1 Lnpf
  s_getpc_b64 s[40:41]
Lpc:
  v_lshlrev_b32 v7, 7, v2
  global_load_dword v27, v7, s[40:41]
  v_add_u32 v7, 0x2000, v7
  v_min_u32 v7, Lend-Lpc, v7
  global_load_dword v27, v7, s[40:41]
  s_cmp_ge_u32 s33, 28
  s_cbranch_scc1 LMskip
  s_cmp_ge_u32 s32, 4
  s_cbranch_scc1 LMskip
  s_cmp_eq_u32 s34, 0
Lnpf:
  s_setprio 3
  s_waitcnt lgkmcnt(0)
  s_cselect_b64 s[40:41], s[10:11], s[16:17]
  global_load_dwordx4 v[8:11], v6, s[4:5]
  global_load_dwordx4 v[12:15], v6, s[4:5] offset:16
Lgo:
  global_load_dwordx4 v[32:35], v5, s[40:41] nt
  v_add_u32 v5, s55, v5
  global_load_dwordx4 v[36:39], v5, s[40:41] nt
  v_add_u32 v5, s55, v5
  global_load_dwordx4 v[40:43], v5, s[40:41] nt
  v_add_u32 v5, s55, v5
  global_load_dwordx4 v[44:47], v5, s[40:41] nt
  v_add_u32 v5, s55, v5
  global_load_dwordx4 v[48:51], v5, s[40:41] nt
  v_add_u32 v5, s55, v5
  global_load_dwordx4 v[52:55], v5, s[40:41] nt
  v_add_u32 v5, s55, v5
  global_load_dwordx4 v[56:59], v5, s[40:41] nt
  v_add_u32 v5, s55, v5
  global_load_dwordx4 v[60:63], v5, s[40:41] nt
  v_add_u32 v5, s55, v5
  global_load_dwordx4 v[64:67], v5, s[40:41] nt
  v_add_u32 v5, s55, v5
  global_load_dwordx4 v[68:71], v5, s[40:41] nt
  v_add_u32 v5, s55, v5
  global_load_dwordx4 v[72:75], v5, s[40:41] nt
  v_add_u32 v5, s55, v5
  global_load_dwordx4 v[76:79], v5, s[40:41] nt
  v_add_u32 v5, s55, v5
  global_load_dwordx4 v[80:83], v5, s[40:41] nt
  v_add_u32 v5, s55, v5
  global_load_dwordx4 v[84:87], v5, s[40:41] nt
  v_add_u32 v5, s55, v5
  global_load_dwordx4 v[88:91], v5, s[40:41] nt
  v_add_u32 v5, s55, v5
  global_load_dwordx4 v[92:95], v5, s[40:41] nt
  s_cbranch_scc0 LM
  s_barrier
  s_load_dword s35, s[30:31], 0
  s_getreg_b32 s39, hwreg(HW_REG_XCC_ID)
  v_mov_b32 v128, 0
  v_mov_b32 v129, 0
  v_mov_b32 v130, 0
  v_mov_b32 v131, 0
  v_mov_b32 v132, 0
  v_mov_b32 v133, 0
  v_mov_b32 v134, 0
  v_mov_b32 v135, 0
  s_and_b32 s39, s39, 7
  s_lshl_b32 s37, s32, 13
  s_add_u32 s37, s37, 65536
  s_lshl_b32 s38, s33, 8
  s_add_u32 s38, s38, s37
  v_lshrrev_b32 v5, 5, v2
  v_lshlrev_b32 v5, 7, v5
  v_lshl_add_u32 v5, v3, 4, v5
  v_add_u32 v5, s38, v5
  v_add_u32 v7, 2621440, v5
  v_lshlrev_b32 v6, 10, v4
  v_lshl_add_u32 v6, v3, 4, v6
  v_add_u32 v6, s37, v6
  v_lshrrev_b32 v140, 4, v2
  v_mul_u32_u24 v140, 320, v140
  v_and_b32 v141, 15, v2
  v_lshl_add_u32 v140, v141, 4, v140
  s_lshl_b32 s37, s32, 17
  s_add_u32 s37, s37, 262144
  v_add_u32 v156, 0, v4
  v_add_u32 v157, s33, v156
  v_and_b32 v157, 31, v157
  v_lshlrev_b32 v156, 12, v156
  v_lshl_add_u32 v156, v157, 7, v156
  v_lshl_add_u32 v156, v3, 4, v156
  v_add_u32 v152, s37, v156
  v_add_u32 v156, 8, v4
  v_add_u32 v157, s33, v156
  v_and_b32 v157, 31, v157
  v_lshlrev_b32 v156, 12, v156
  v_lshl_add_u32 v156, v157, 7, v156
  v_lshl_add_u32 v156, v3, 4, v156
  v_add_u32 v153, s37, v156
  v_add_u32 v156, 16, v4
  v_add_u32 v157, s33, v156
  v_and_b32 v157, 31, v157
  v_lshlrev_b32 v156, 12, v156
  v_lshl_add_u32 v156, v157, 7, v156
  v_lshl_add_u32 v156, v3, 4, v156
  v_add_u32 v154, s37, v156
  v_add_u32 v156, 24, v4
  v_add_u32 v157, s33, v156
  v_and_b32 v157, 31, v157
  v_lshlrev_b32 v156, 12, v156
  v_lshl_add_u32 v156, v157, 7, v156
  v_lshl_add_u32 v156, v3, 4, v156
  v_add_u32 v155, s37, v156
  s_lshl_b32 s37, s33, 10
  s_lshl_b32 s38, s32, 7
  s_add_u32 s37, s37, s38
  s_add_u32 s37, s37, 32768
  v_lshl_add_u32 v143, v2, 4, s37
  v_lshlrev_b32 v142, 4, v3
  v_add_u32 v142, 1472, v142
  v_mov_b32 v144, 1304
  s_mov_b32 s44, 0x07060503
  s_mov_b32 s45, 0x07060502
  s_mov_b32 s46, 0x07060501
  s_mov_b32 s47, 0x04000c0c
  s_mov_b32 s48, 0x0706000c
  s_waitcnt vmcnt(16)
  v_and_b32 v96, 0xffff, v8
  v_lshlrev_b32 v97, 16, v8
  v_lshrrev_b32 v98, 16, v8
  v_and_b32 v99, 0xffff0000, v8
  v_and_b32 v100, 0xffff, v9
  v_lshlrev_b32 v101, 16, v9
  v_lshrrev_b32 v102, 16, v9
  v_and_b32 v103, 0xffff0000, v9
  v_and_b32 v104, 0xffff, v10
  v_lshlrev_b32 v105, 16, v10
  v_lshrrev_b32 v106, 16, v10
  v_and_b32 v107, 0xffff0000, v10
  v_and_b32 v108, 0xffff, v11
  v_lshlrev_b32 v109, 16, v11
  v_lshrrev_b32 v110, 16, v11
  v_and_b32 v111, 0xffff0000, v11
  v_and_b32 v112, 0xffff, v12
  v_lshlrev_b32 v113, 16, v12
  v_lshrrev_b32 v114, 16, v12
  v_and_b32 v115, 0xffff0000, v12
  v_and_b32 v116, 0xffff, v13
  v_lshlrev_b32 v117, 16, v13
  v_lshrrev_b32 v118, 16, v13
  v_and_b32 v119, 0xffff0000, v13
  v_and_b32 v120, 0xffff, v14
  v_lshlrev_b32 v121, 16, v14
  v_lshrrev_b32 v122, 16, v14
  v_and_b32 v123, 0xffff0000, v14
  v_and_b32 v124, 0xffff, v15
  v_lshlrev_b32 v125, 16, v15
  v_lshrrev_b32 v126, 16, v15
  v_and_b32 v127, 0xffff0000, v15
  s_waitcnt vmcnt(15)
  v_dot2c_f32_bf16 v128, v32, v96
  v_dot2c_f32_bf16 v129, v32, v97
  v_dot2c_f32_bf16 v130, v33, v96
  v_dot2c_f32_bf16 v131, v33, v97
  v_dot2c_f32_bf16 v132, v34, v96
  v_dot2c_f32_bf16 v133, v34, v97
  v_dot2c_f32_bf16 v134, v35, v96
  v_dot2c_f32_bf16 v135, v35, v97
  s_waitcnt vmcnt(14)
  v_dot2c_f32_bf16 v128, v36, v98
  v_dot2c_f32_bf16 v129, v36, v99
  v_dot2c_f32_bf16 v130, v37, v98
  v_dot2c_f32_bf16 v131, v37, v99
  v_dot2c_f32_bf16 v132, v38, v98
  v_dot2c_f32_bf16 v133, v38, v99
  v_dot2c_f32_bf16 v134, v39, v98
  v_dot2c_f32_bf16 v135, v39, v99
  s_waitcnt vmcnt(13)
  v_dot2c_f32_bf16 v128, v40, v100
  v_dot2c_f32_bf16 v129, v40, v101
  v_dot2c_f32_bf16 v130, v41, v100
  v_dot2c_f32_bf16 v131, v41, v101
  v_dot2c_f32_bf16 v132, v42, v100
  v_dot2c_f32_bf16 v133, v42, v101
  v_dot2c_f32_bf16 v134, v43, v100
  v_dot2c_f32_bf16 v135, v43, v101
  s_waitcnt vmcnt(12)
  v_dot2c_f32_bf16 v128, v44, v102
  v_dot2c_f32_bf16 v129, v44, v103
  v_dot2c_f32_bf16 v130, v45, v102
  v_dot2c_f32_bf16 v131, v45, v103
  v_dot2c_f32_bf16 v132, v46, v102
  v_dot2c_f32_bf16 v133, v46, v103
  v_dot2c_f32_bf16 v134, v47, v102
  v_dot2c_f32_bf16 v135, v47, v103
  s_waitcnt vmcnt(11)
  v_dot2c_f32_bf16 v128, v48, v104
  v_dot2c_f32_bf16 v129, v48, v105
  v_dot2c_f32_bf16 v130, v49, v104
  v_dot2c_f32_bf16 v131, v49, v105
  v_dot2c_f32_bf16 v132, v50, v104
  v_dot2c_f32_bf16 v133, v50, v105
  v_dot2c_f32_bf16 v134, v51, v104
  v_dot2c_f32_bf16 v135, v51, v105
  s_waitcnt vmcnt(10)
  v_dot2c_f32_bf16 v128, v52, v106
  v_dot2c_f32_bf16 v129, v52, v107
  v_dot2c_f32_bf16 v130, v53, v106
  v_dot2c_f32_bf16 v131, v53, v107
  v_dot2c_f32_bf16 v132, v54, v106
  v_dot2c_f32_bf16 v133, v54, v107
  v_dot2c_f32_bf16 v134, v55, v106
  v_dot2c_f32_bf16 v135, v55, v107
  s_waitcnt vmcnt(9)
  v_dot2c_f32_bf16 v128, v56, v108
  v_dot2c_f32_bf16 v129, v56, v109
  v_dot2c_f32_bf16 v130, v57, v108
  v_dot2c_f32_bf16 v131, v57, v109
  v_dot2c_f32_bf16 v132, v58, v108
  v_dot2c_f32_bf16 v133, v58, v109
  v_dot2c_f32_bf16 v134, v59, v108
  v_dot2c_f32_bf16 v135, v59, v109
  s_waitcnt vmcnt(8)
  v_dot2c_f32_bf16 v128, v60, v110
  v_dot2c_f32_bf16 v129, v60, v111
  v_dot2c_f32_bf16 v130, v61, v110
  v_dot2c_f32_bf16 v131, v61, v111
  v_dot2c_f32_bf16 v132, v62, v110
  v_dot2c_f32_bf16 v133, v62, v111
  v_dot2c_f32_bf16 v134, v63, v110
  v_dot2c_f32_bf16 v135, v63, v111
  s_waitcnt vmcnt(7)
  v_dot2c_f32_bf16 v128, v64, v112
  v_dot2c_f32_bf16 v129, v64, v113
  v_dot2c_f32_bf16 v130, v65, v112
  v_dot2c_f32_bf16 v131, v65, v113
  v_dot2c_f32_bf16 v132, v66, v112
  v_dot2c_f32_bf16 v133, v66, v113
  v_dot2c_f32_bf16 v134, v67, v112
  v_dot2c_f32_bf16 v135, v67, v113
  s_waitcnt vmcnt(6)
  v_dot2c_f32_bf16 v128, v68, v114
  v_dot2c_f32_bf16 v129, v68, v115
  v_dot2c_f32_bf16 v130, v69, v114
  v_dot2c_f32_bf16 v131, v69, v115
  v_dot2c_f32_bf16 v132, v70, v114
  v_dot2c_f32_bf16 v133, v70, v115
  v_dot2c_f32_bf16 v134, v71, v114
  v_dot2c_f32_bf16 v135, v71, v115
  s_waitcnt vmcnt(5)
  v_dot2c_f32_bf16 v128, v72, v116
  v_dot2c_f32_bf16 v129, v72, v117
  v_dot2c_f32_bf16 v130, v73, v116
  v_dot2c_f32_bf16 v131, v73, v117
  v_dot2c_f32_bf16 v132, v74, v116
  v_dot2c_f32_bf16 v133, v74, v117
  v_dot2c_f32_bf16 v134, v75, v116
  v_dot2c_f32_bf16 v135, v75, v117
  s_waitcnt vmcnt(4)
  v_dot2c_f32_bf16 v128, v76, v118
  v_dot2c_f32_bf16 v129, v76, v119
  v_dot2c_f32_bf16 v130, v77, v118
  v_dot2c_f32_bf16 v131, v77, v119
  v_dot2c_f32_bf16 v132, v78, v118
  v_dot2c_f32_bf16 v133, v78, v119
  v_dot2c_f32_bf16 v134, v79, v118
  v_dot2c_f32_bf16 v135, v79, v119
  s_waitcnt vmcnt(3)
  v_dot2c_f32_bf16 v128, v80, v120
  v_dot2c_f32_bf16 v129, v80, v121
  v_dot2c_f32_bf16 v130, v81, v120
  v_dot2c_f32_bf16 v131, v81, v121
  v_dot2c_f32_bf16 v132, v82, v120
  v_dot2c_f32_bf16 v133, v82, v121
  v_dot2c_f32_bf16 v134, v83, v120
  v_dot2c_f32_bf16 v135, v83, v121
  s_waitcnt vmcnt(2)
  v_dot2c_f32_bf16 v128, v84, v122
  v_dot2c_f32_bf16 v129, v84, v123
  v_dot2c_f32_bf16 v130, v85, v122
  v_dot2c_f32_bf16 v131, v85, v123
  v_dot2c_f32_bf16 v132, v86, v122
  v_dot2c_f32_bf16 v133, v86, v123
  v_dot2c_f32_bf16 v134, v87, v122
  v_dot2c_f32_bf16 v135, v87, v123
  s_waitcnt vmcnt(1)
  v_dot2c_f32_bf16 v128, v88, v124
  v_dot2c_f32_bf16 v129, v88, v125
  v_dot2c_f32_bf16 v130, v89, v124
  v_dot2c_f32_bf16 v131, v89, v125
  v_dot2c_f32_bf16 v132, v90, v124
  v_dot2c_f32_bf16 v133, v90, v125
  v_dot2c_f32_bf16 v134, v91, v124
  v_dot2c_f32_bf16 v135, v91, v125
  s_waitcnt vmcnt(0)
  v_dot2c_f32_bf16 v128, v92, v126
  v_dot2c_f32_bf16 v129, v92, v127
  v_dot2c_f32_bf16 v130, v93, v126
  v_dot2c_f32_bf16 v131, v93, v127
  v_dot2c_f32_bf16 v132, v94, v126
  v_dot2c_f32_bf16 v133, v94, v127
  v_dot2c_f32_bf16 v134, v95, v126
  v_dot2c_f32_bf16 v135, v95, v127
  s_waitcnt lgkmcnt(0)
  s_and_b32 s36, s35, 0xfffffff8
  s_add_u32 s36, s36, 0x9e3779b8
  s_or_b32 s43, s36, s39
  v_permlane32_swap_b32 v128, v132
  v_permlane32_swap_b32 v129, v133
  v_permlane32_swap_b32 v130, v134
  v_permlane32_swap_b32 v131, v135
  v_add_f32 v128, v128, v132
  v_add_f32 v129, v129, v133
  v_add_f32 v130, v130, v134
  v_add_f32 v131, v131, v135
  v_add_f32_dpp v128, v128, v128 row_ror:8 row_mask:0xf bank_mask:0xf
  v_add_f32_dpp v129, v129, v129 row_ror:8 row_mask:0xf bank_mask:0xf
  v_add_f32_dpp v130, v130, v130 row_ror:8 row_mask:0xf bank_mask:0xf
  v_add_f32_dpp v131, v131, v131 row_ror:8 row_mask:0xf bank_mask:0xf
  v_mov_b32 v132, v128
  v_mov_b32 v133, v129
  v_mov_b32 v134, v130
  v_mov_b32 v135, v131
  v_permlane16_swap_b32 v128, v132
  v_permlane16_swap_b32 v129, v133
  v_permlane16_swap_b32 v130, v134
  v_permlane16_swap_b32 v131, v135
  v_add_f32 v128, v128, v132
  v_add_f32 v129, v129, v133
  v_add_f32 v130, v130, v134
  v_add_f32 v131, v131, v135
  v_perm_b32 v128, v128, v131, s44
  v_perm_b32 v129, v129, v131, s45
  v_perm_b32 v130, v130, v131, s46
  v_add3_u32 v131, v128, v129, v130
  v_add_u32 v131, s43, v131
  s_mov_b32 exec_lo, 0xff
  s_mov_b32 exec_hi, 0xff
  global_store_dwordx4 v5, v[128:131], s[30:31]
  s_mov_b64 exec, -1
  s_barrier
  s_mov_b64 s[4:5], -1
  s_mov_b64 s[6:7], -1
  s_mov_b64 s[8:9], -1
  s_mov_b64 s[10:11], -1
  s_mov_b64 s[12:13], -1
  s_mov_b64 s[14:15], -1
  s_mov_b64 s[16:17], -1
  s_mov_b64 s[18:19], -1
  s_mov_b32 s42, 0
  global_load_dwordx4 v[32:35], v6, s[30:31] offset:0 sc1
  global_load_dwordx4 v[36:39], v6, s[30:31] offset:128 sc1
  global_load_dwordx4 v[40:43], v6, s[30:31] offset:256 sc1
  global_load_dwordx4 v[44:47], v6, s[30:31] offset:384 sc1
  global_load_dwordx4 v[48:51], v6, s[30:31] offset:512 sc1
  global_load_dwordx4 v[52:55], v6, s[30:31] offset:640 sc1
  global_load_dwordx4 v[56:59], v6, s[30:31] offset:768 sc1
  global_load_dwordx4 v[60:63], v6, s[30:31] offset:896 sc1
  s_barrier
  s_branch LQiss
LQpoll:
  s_cmp_lt_u32 s42, 6
  s_cbranch_scc1 LQpa
  v_xor_b32 v6, 2621440, v6
LQpa:
  s_mov_b64 exec, s[4:5]
  global_load_dwordx4 v[32:35], v6, s[30:31] offset:0 sc1
  s_mov_b64 exec, s[6:7]
  global_load_dwordx4 v[36:39], v6, s[30:31] offset:128 sc1
  s_mov_b64 exec, s[8:9]
  global_load_dwordx4 v[40:43], v6, s[30:31] offset:256 sc1
  s_mov_b64 exec, s[10:11]
  global_load_dwordx4 v[44:47], v6, s[30:31] offset:384 sc1
  s_mov_b64 exec, s[12:13]
  global_load_dwordx4 v[48:51], v6, s[30:31] offset:512 sc1
  s_mov_b64 exec, s[14:15]
  global_load_dwordx4 v[52:55], v6, s[30:31] offset:640 sc1
  s_mov_b64 exec, s[16:17]
  global_load_dwordx4 v[56:59], v6, s[30:31] offset:768 sc1
  s_mov_b64 exec, s[18:19]
  global_load_dwordx4 v[60:63], v6, s[30:31] offset:896 sc1
  s_mov_b64 exec, -1
LQiss:
  s_add_u32 s42, s42, 1
  s_waitcnt vmcnt(7)
  v_add3_u32 v8, v32, v33, v34
  v_perm_b32 v72, v32, v33, s47
  v_sub_u32 v8, v35, v8
  v_perm_b32 v72, v72, v34, s48
  v_xor_b32 v8, s43, v8
  v_cmp_le_u32 s[4:5], 8, v8
  s_waitcnt vmcnt(6)
  v_add3_u32 v9, v36, v37, v38
  v_perm_b32 v73, v36, v37, s47
  v_sub_u32 v9, v39, v9
  v_perm_b32 v73, v73, v38, s48
  v_xor_b32 v9, s43, v9
  v_cmp_le_u32 s[6:7], 8, v9
  s_waitcnt vmcnt(5)
  v_add3_u32 v10, v40, v41, v42
  v_perm_b32 v74, v40, v41, s47
  v_sub_u32 v10, v43, v10
  v_perm_b32 v74, v74, v42, s48
  v_xor_b32 v10, s43, v10
  v_add_f32 v64, v32, v40
  v_add_f32 v65, v33, v41
  v_add_f32 v66, v34, v42
  v_add_f32 v67, v72, v74
  v_cmp_le_u32 s[8:9], 8, v10
  s_waitcnt vmcnt(4)
  v_add3_u32 v11, v44, v45, v46
  v_perm_b32 v75, v44, v45, s47
  v_sub_u32 v11, v47, v11
  v_perm_b32 v75, v75, v46, s48
  v_xor_b32 v11, s43, v11
  v_add_f32 v68, v36, v44
  v_add_f32 v69, v37, v45
  v_add_f32 v70, v38, v46
  v_add_f32 v71, v73, v75
  v_cmp_le_u32 s[10:11], 8, v11
  s_waitcnt vmcnt(3)
  v_add3_u32 v12, v48, v49, v50
  v_perm_b32 v76, v48, v49, s47
  v_sub_u32 v12, v51, v12
  v_perm_b32 v76, v76, v50, s48
  v_xor_b32 v12, s43, v12
  v_add_f32 v64, v64, v48
  v_add_f32 v65, v65, v49
  v_add_f32 v66, v66, v50
  v_add_f32 v67, v67, v76
  v_cmp_le_u32 s[12:13], 8, v12
  s_waitcnt vmcnt(2)
  v_add3_u32 v13, v52, v53, v54
  v_perm_b32 v77, v52, v53, s47
  v_sub_u32 v13, v55, v13
  v_perm_b32 v77, v77, v54, s48
  v_xor_b32 v13, s43, v13
  v_add_f32 v68, v68, v52
  v_add_f32 v69, v69, v53
  v_add_f32 v70, v70, v54
  v_add_f32 v71, v71, v77
  v_cmp_le_u32 s[14:15], 8, v13
  s_waitcnt vmcnt(1)
  v_add3_u32 v14, v56, v57, v58
  v_perm_b32 v78, v56, v57, s47
  v_sub_u32 v14, v59, v14
  v_perm_b32 v78, v78, v58, s48
  v_xor_b32 v14, s43, v14
  v_add_f32 v64, v64, v56
  v_add_f32 v65, v65, v57
  v_add_f32 v66, v66, v58
  v_add_f32 v67, v67, v78
  v_cmp_le_u32 s[16:17], 8, v14
  v_cvt_pk_bf16_f32 v80, v64, v65
  v_cvt_pk_bf16_f32 v81, v66, v67
  s_waitcnt vmcnt(0)
  v_add3_u32 v15, v60, v61, v62
  v_perm_b32 v79, v60, v61, s47
  v_sub_u32 v15, v63, v15
  v_perm_b32 v79, v79, v62, s48
  v_xor_b32 v15, s43, v15
  v_add_f32 v68, v68, v60
  v_add_f32 v69, v69, v61
  v_add_f32 v70, v70, v62
  v_add_f32 v71, v71, v79
  v_cmp_le_u32 s[18:19], 8, v15
  v_cvt_pk_bf16_f32 v82, v68, v69
  v_cvt_pk_bf16_f32 v83, v70, v71
  ds_write_b128 v140, v[80:83]
  s_or_b64 s[40:41], s[4:5], s[6:7]
  s_or_b64 s[50:51], s[8:9], s[10:11]
  s_or_b64 s[52:53], s[12:13], s[14:15]
  s_or_b64 vcc, s[16:17], s[18:19]
  s_or_b64 s[40:41], s[40:41], s[50:51]
  s_or_b64 vcc, vcc, s[52:53]
  s_or_b64 s[40:41], s[40:41], vcc
  s_cbranch_scc0 LQgot
  s_cmp_lg_u32 s42, 2
  s_cbranch_scc1 LQnb
  s_mov_b32 exec_lo, 0xff
  s_mov_b32 exec_hi, 0xff
  global_store_dwordx4 v7, v[128:131], s[30:31] sc1
LQnb:
  s_cmp_lt_u32 s42, 1048576
  s_cbranch_scc1 LQpoll
LQgot:
  v_or3_b32 v8, v8, v9, v10
  v_or3_b32 v11, v11, v12, v13
  v_or3_b32 v8, v8, v14, v15
  v_or_b32 v8, v8, v11
  v_cmp_ne_u32 vcc, 0, v8
  s_cmp_eq_u64 vcc, 0
  s_cselect_b32 s57, 1, 0
  s_cmp_eq_u32 s57, 0
  s_cbranch_scc1 LQsb
LQsbr:
  v_mov_b32 v4, s57
  ds_write_b32 v144, v4
  s_waitcnt lgkmcnt(0)
  s_barrier
  s_cmp_eq_u32 s57, 0
  s_cselect_b32 s58, 8388608, 0
  s_add_u32 s58, s30, s58
  s_addc_u32 s59, s31, 0
  s_barrier
  s_barrier
  s_add_u32 s39, s36, 1540483472
  s_mov_b64 s[44:45], -1
  s_mov_b64 s[46:47], -1
  s_mov_b64 s[48:49], -1
  s_mov_b64 s[50:51], -1
  s_mov_b32 s42, 0
LFpoll:
  s_mov_b64 exec, s[44:45]
  s_cbranch_execz LFs0
  global_load_dwordx3 v[8:10], v152, s[58:59] sc1
LFs0:
  s_mov_b64 exec, s[46:47]
  s_cbranch_execz LFs1
  global_load_dwordx3 v[12:14], v153, s[58:59] sc1
LFs1:
  s_mov_b64 exec, s[48:49]
  s_cbranch_execz LFs2
  global_load_dwordx3 v[16:18], v154, s[58:59] sc1
LFs2:
  s_mov_b64 exec, s[50:51]
  s_cbranch_execz LFs3
  global_load_dwordx3 v[20:22], v155, s[58:59] sc1
LFs3:
  s_mov_b64 exec, -1
  s_add_u32 s42, s42, 1
  s_waitcnt vmcnt(0)
  v_add3_u32 v24, v8, v9, s39
  v_add3_u32 v25, v12, v13, s39
  v_add3_u32 v26, v16, v17, s39
  v_add3_u32 v27, v20, v21, s39
  v_add_f32 v28, v8, v12
  v_add_f32 v29, v9, v13
  v_cmp_ne_u32 s[44:45], v24, v10
  v_cmp_ne_u32 s[46:47], v25, v14
  v_cmp_ne_u32 s[48:49], v26, v18
  v_cmp_ne_u32 s[50:51], v27, v22
  v_add_f32 v30, v16, v20
  v_add_f32 v31, v17, v21
  v_add_f32 v28, v28, v30
  v_add_f32 v29, v29, v31
  s_or_b64 s[40:41], s[44:45], s[46:47]
  s_or_b64 vcc, s[48:49], s[50:51]
  s_or_b64 s[40:41], s[40:41], vcc
  s_cbranch_scc0 LFgot
  s_cmp_lt_u32 s42, 1048576
  s_cbranch_scc1 LFpoll
LFgot:
  v_add_f32_dpp v28, v28, v28 row_ror:8 row_mask:0xf bank_mask:0xf
  v_add_f32_dpp v29, v29, v29 row_ror:8 row_mask:0xf bank_mask:0xf
  v_mov_b32 v36, v28
  v_mov_b32 v37, v29
  s_nop 0
  v_permlane32_swap_b32 v28, v36
  v_permlane32_swap_b32 v29, v37
  v_add_f32 v28, v28, v36
  v_add_f32 v29, v29, v37
  v_mov_b32 v36, v28
  v_mov_b32 v37, v29
  s_nop 0
  v_permlane16_swap_b32 v28, v36
  v_permlane16_swap_b32 v29, v37
  v_add_f32 v28, v28, v36
  v_add_f32 v29, v29, v37
  v_add3_u32 v30, v28, v29, s36
  s_mov_b64 exec, 0xff
  global_store_dwordx4 v143, v[28:31], s[30:31] sc1
  ds_write_b96 v142, v[28:30]
  s_endpgm
LMskip:
  s_waitcnt lgkmcnt(0)
  v_lshlrev_b32 v6, 4, v2
  global_load_dwordx4 v[16:19], v6, s[4:5]
  global_load_dwordx4 v[20:23], v6, s[24:25]
  s_lshl_b32 s37, s33, 5
  v_lshl_add_u32 v144, v3, 2, s37
  global_load_dword v145, v144, s[22:23]
  s_barrier
  s_load_dword s35, s[30:31], 0
  s_waitcnt vmcnt(0) lgkmcnt(0)
  s_and_b32 s36, s35, 0xfffffff8
  s_add_u32 s36, s36, 0x9e3779b8
  s_mov_b32 s56, 0
  s_branch LMgate
LM:
  v_lshlrev_b32 v6, 4, v2
  global_load_dwordx4 v[16:19], v6, s[4:5]
  global_load_dwordx4 v[20:23], v6, s[24:25]
  s_lshl_b32 s37, s33, 5
  v_lshl_add_u32 v144, v3, 2, s37
  global_load_dword v145, v144, s[22:23]
  s_barrier
  s_load_dword s35, s[30:31], 0
  v_mov_b32 v128, 0
  v_mov_b32 v129, 0
  v_mov_b32 v130, 0
  v_mov_b32 v131, 0
  v_mov_b32 v132, 0
  v_mov_b32 v133, 0
  v_mov_b32 v134, 0
  v_mov_b32 v135, 0
  s_lshl_b32 s37, s33, 12
  s_add_u32 s37, s37, 131072
  s_lshl_b32 s38, s32, 9
  s_add_u32 s38, s38, s37
  v_lshl_add_u32 v5, v3, 3, v4
  v_lshl_add_u32 v5, v5, 3, s38
  s_waitcnt vmcnt(19)
  v_and_b32 v96, 0xffff, v8
  v_lshlrev_b32 v97, 16, v8
  v_lshrrev_b32 v98, 16, v8
  v_and_b32 v99, 0xffff0000, v8
  v_and_b32 v100, 0xffff, v9
  v_lshlrev_b32 v101, 16, v9
  v_lshrrev_b32 v102, 16, v9
  v_and_b32 v103, 0xffff0000, v9
  v_and_b32 v104, 0xffff, v10
  v_lshlrev_b32 v105, 16, v10
  v_lshrrev_b32 v106, 16, v10
  v_and_b32 v107, 0xffff0000, v10
  v_and_b32 v108, 0xffff, v11
  v_lshlrev_b32 v109, 16, v11
  v_lshrrev_b32 v110, 16, v11
  v_and_b32 v111, 0xffff0000, v11
  v_and_b32 v112, 0xffff, v12
  v_lshlrev_b32 v113, 16, v12
  v_lshrrev_b32 v114, 16, v12
  v_and_b32 v115, 0xffff0000, v12
  v_and_b32 v116, 0xffff, v13
  v_lshlrev_b32 v117, 16, v13
  v_lshrrev_b32 v118, 16, v13
  v_and_b32 v119, 0xffff0000, v13
  v_and_b32 v120, 0xffff, v14
  v_lshlrev_b32 v121, 16, v14
  v_lshrrev_b32 v122, 16, v14
  v_and_b32 v123, 0xffff0000, v14
  v_and_b32 v124, 0xffff, v15
  v_lshlrev_b32 v125, 16, v15
  v_lshrrev_b32 v126, 16, v15
  v_and_b32 v127, 0xffff0000, v15
  s_waitcnt vmcnt(18)
  v_dot2c_f32_bf16 v128, v32, v96
  v_dot2c_f32_bf16 v129, v32, v97
  v_dot2c_f32_bf16 v130, v33, v96
  v_dot2c_f32_bf16 v131, v33, v97
  v_dot2c_f32_bf16 v132, v34, v96
  v_dot2c_f32_bf16 v133, v34, v97
  v_dot2c_f32_bf16 v134, v35, v96
  v_dot2c_f32_bf16 v135, v35, v97
  s_waitcnt vmcnt(17)
  v_dot2c_f32_bf16 v128, v36, v98
  v_dot2c_f32_bf16 v129, v36, v99
  v_dot2c_f32_bf16 v130, v37, v98
  v_dot2c_f32_bf16 v131, v37, v99
  v_dot2c_f32_bf16 v132, v38, v98
  v_dot2c_f32_bf16 v133, v38, v99
  v_dot2c_f32_bf16 v134, v39, v98
  v_dot2c_f32_bf16 v135, v39, v99
  s_waitcnt vmcnt(16)
  v_dot2c_f32_bf16 v128, v40, v100
  v_dot2c_f32_bf16 v129, v40, v101
  v_dot2c_f32_bf16 v130, v41, v100
  v_dot2c_f32_bf16 v131, v41, v101
  v_dot2c_f32_bf16 v132, v42, v100
  v_dot2c_f32_bf16 v133, v42, v101
  v_dot2c_f32_bf16 v134, v43, v100
  v_dot2c_f32_bf16 v135, v43, v101
  s_waitcnt vmcnt(15)
  v_dot2c_f32_bf16 v128, v44, v102
  v_dot2c_f32_bf16 v129, v44, v103
  v_dot2c_f32_bf16 v130, v45, v102
  v_dot2c_f32_bf16 v131, v45, v103
  v_dot2c_f32_bf16 v132, v46, v102
  v_dot2c_f32_bf16 v133, v46, v103
  v_dot2c_f32_bf16 v134, v47, v102
  v_dot2c_f32_bf16 v135, v47, v103
  s_waitcnt vmcnt(14)
  v_dot2c_f32_bf16 v128, v48, v104
  v_dot2c_f32_bf16 v129, v48, v105
  v_dot2c_f32_bf16 v130, v49, v104
  v_dot2c_f32_bf16 v131, v49, v105
  v_dot2c_f32_bf16 v132, v50, v104
  v_dot2c_f32_bf16 v133, v50, v105
  v_dot2c_f32_bf16 v134, v51, v104
  v_dot2c_f32_bf16 v135, v51, v105
  s_waitcnt vmcnt(13)
  v_dot2c_f32_bf16 v128, v52, v106
  v_dot2c_f32_bf16 v129, v52, v107
  v_dot2c_f32_bf16 v130, v53, v106
  v_dot2c_f32_bf16 v131, v53, v107
  v_dot2c_f32_bf16 v132, v54, v106
  v_dot2c_f32_bf16 v133, v54, v107
  v_dot2c_f32_bf16 v134, v55, v106
  v_dot2c_f32_bf16 v135, v55, v107
  s_waitcnt vmcnt(12)
  v_dot2c_f32_bf16 v128, v56, v108
  v_dot2c_f32_bf16 v129, v56, v109
  v_dot2c_f32_bf16 v130, v57, v108
  v_dot2c_f32_bf16 v131, v57, v109
  v_dot2c_f32_bf16 v132, v58, v108
  v_dot2c_f32_bf16 v133, v58, v109
  v_dot2c_f32_bf16 v134, v59, v108
  v_dot2c_f32_bf16 v135, v59, v109
  s_waitcnt vmcnt(11)
  v_dot2c_f32_bf16 v128, v60, v110
  v_dot2c_f32_bf16 v129, v60, v111
  v_dot2c_f32_bf16 v130, v61, v110
  v_dot2c_f32_bf16 v131, v61, v111
  v_dot2c_f32_bf16 v132, v62, v110
  v_dot2c_f32_bf16 v133, v62, v111
  v_dot2c_f32_bf16 v134, v63, v110
  v_dot2c_f32_bf16 v135, v63, v111
  s_waitcnt vmcnt(10)
  v_dot2c_f32_bf16 v128, v64, v112
  v_dot2c_f32_bf16 v129, v64, v113
  v_dot2c_f32_bf16 v130, v65, v112
  v_dot2c_f32_bf16 v131, v65, v113
  v_dot2c_f32_bf16 v132, v66, v112
  v_dot2c_f32_bf16 v133, v66, v113
  v_dot2c_f32_bf16 v134, v67, v112
  v_dot2c_f32_bf16 v135, v67, v113
  s_waitcnt vmcnt(9)
  v_dot2c_f32_bf16 v128, v68, v114
  v_dot2c_f32_bf16 v129, v68, v115
  v_dot2c_f32_bf16 v130, v69, v114
  v_dot2c_f32_bf16 v131, v69, v115
  v_dot2c_f32_bf16 v132, v70, v114
  v_dot2c_f32_bf16 v133, v70, v115
  v_dot2c_f32_bf16 v134, v71, v114
  v_dot2c_f32_bf16 v135, v71, v115
  s_waitcnt vmcnt(8)
  v_dot2c_f32_bf16 v128, v72, v116
  v_dot2c_f32_bf16 v129, v72, v117
  v_dot2c_f32_bf16 v130, v73, v116
  v_dot2c_f32_bf16 v131, v73, v117
  v_dot2c_f32_bf16 v132, v74, v116
  v_dot2c_f32_bf16 v133, v74, v117
  v_dot2c_f32_bf16 v134, v75, v116
  v_dot2c_f32_bf16 v135, v75, v117
  s_waitcnt vmcnt(7)
  v_dot2c_f32_bf16 v128, v76, v118
  v_dot2c_f32_bf16 v129, v76, v119
  v_dot2c_f32_bf16 v130, v77, v118
  v_dot2c_f32_bf16 v131, v77, v119
  v_dot2c_f32_bf16 v132, v78, v118
  v_dot2c_f32_bf16 v133, v78, v119
  v_dot2c_f32_bf16 v134, v79, v118
  v_dot2c_f32_bf16 v135, v79, v119
  s_waitcnt vmcnt(6)
  v_dot2c_f32_bf16 v128, v80, v120
  v_dot2c_f32_bf16 v129, v80, v121
  v_dot2c_f32_bf16 v130, v81, v120
  v_dot2c_f32_bf16 v131, v81, v121
  v_dot2c_f32_bf16 v132, v82, v120
  v_dot2c_f32_bf16 v133, v82, v121
  v_dot2c_f32_bf16 v134, v83, v120
  v_dot2c_f32_bf16 v135, v83, v121
  s_waitcnt vmcnt(5)
  v_dot2c_f32_bf16 v128, v84, v122
  v_dot2c_f32_bf16 v129, v84, v123
  v_dot2c_f32_bf16 v130, v85, v122
  v_dot2c_f32_bf16 v131, v85, v123
  v_dot2c_f32_bf16 v132, v86, v122
  v_dot2c_f32_bf16 v133, v86, v123
  v_dot2c_f32_bf16 v134, v87, v122
  v_dot2c_f32_bf16 v135, v87, v123
  s_waitcnt vmcnt(4)
  v_dot2c_f32_bf16 v128, v88, v124
  v_dot2c_f32_bf16 v129, v88, v125
  v_dot2c_f32_bf16 v130, v89, v124
  v_dot2c_f32_bf16 v131, v89, v125
  v_dot2c_f32_bf16 v132, v90, v124
  v_dot2c_f32_bf16 v133, v90, v125
  v_dot2c_f32_bf16 v134, v91, v124
  v_dot2c_f32_bf16 v135, v91, v125
  s_waitcnt vmcnt(3)
  v_dot2c_f32_bf16 v128, v92, v126
  v_dot2c_f32_bf16 v129, v92, v127
  v_dot2c_f32_bf16 v130, v93, v126
  v_dot2c_f32_bf16 v131, v93, v127
  v_dot2c_f32_bf16 v132, v94, v126
  v_dot2c_f32_bf16 v133, v94, v127
  v_dot2c_f32_bf16 v134, v95, v126
  v_dot2c_f32_bf16 v135, v95, v127
  s_waitcnt lgkmcnt(0)
  s_and_b32 s36, s35, 0xfffffff8
  s_add_u32 s36, s36, 0x9e3779b8
  v_permlane32_swap_b32 v128, v132
  v_permlane32_swap_b32 v129, v133
  v_permlane32_swap_b32 v130, v134
  v_permlane32_swap_b32 v131, v135
  v_add_f32 v128, v128, v132
  v_add_f32 v129, v129, v133
  v_add_f32 v130, v130, v134
  v_add_f32 v131, v131, v135
  s_nop 0
  v_permlane16_swap_b32 v128, v130
  v_permlane16_swap_b32 v129, v131
  v_add_f32 v128, v128, v130
  v_add_f32 v129, v129, v131
  s_nop 0
  v_add_f32_dpp v128, v128, v128 row_ror:8 row_mask:0xf bank_mask:0x3
  v_add_f32_dpp v128, v129, v129 row_ror:8 row_mask:0xf bank_mask:0xc
  v_xor_b32 v129, s36, v128
  global_store_dwordx2 v5, v[128:129], s[30:31] sc1
  s_waitcnt vmcnt(1)
LMgate:
  v_lshlrev_b32 v80, 16, v16
  v_and_b32 v81, 0xffff0000, v16
  v_lshlrev_b32 v88, 16, v20
  v_and_b32 v89, 0xffff0000, v20
  v_lshlrev_b32 v82, 16, v17
  v_and_b32 v83, 0xffff0000, v17
  v_lshlrev_b32 v90, 16, v21
  v_and_b32 v91, 0xffff0000, v21
  v_lshlrev_b32 v84, 16, v18
  v_and_b32 v85, 0xffff0000, v18
  v_lshlrev_b32 v92, 16, v22
  v_and_b32 v93, 0xffff0000, v22
  v_lshlrev_b32 v86, 16, v19
  v_and_b32 v87, 0xffff0000, v19
  v_lshlrev_b32 v94, 16, v23
  v_and_b32 v95, 0xffff0000, v23
  v_mul_f32 v80, v80, v88
  v_mul_f32 v81, v81, v89
  v_mul_f32 v82, v82, v90
  v_mul_f32 v83, v83, v91
  v_mul_f32 v84, v84, v92
  v_mul_f32 v85, v85, v93
  v_mul_f32 v86, v86, v94
  v_mul_f32 v87, v87, v95
  v_cvt_pk_bf16_f32 v88, v80, v81
  v_cvt_pk_bf16_f32 v89, v82, v83
  v_cvt_pk_bf16_f32 v90, v84, v85
  v_cvt_pk_bf16_f32 v91, v86, v87
  v_lshlrev_b32 v80, 16, v88
  v_and_b32 v81, 0xffff0000, v88
  v_lshlrev_b32 v82, 16, v89
  v_and_b32 v83, 0xffff0000, v89
  v_lshlrev_b32 v84, 16, v90
  v_and_b32 v85, 0xffff0000, v90
  v_lshlrev_b32 v86, 16, v91
  v_and_b32 v87, 0xffff0000, v91
  v_add_f32 v80, v80, v81
  v_add_f32 v82, v82, v83
  v_add_f32 v84, v84, v85
  v_add_f32 v86, v86, v87
  v_add_f32 v80, v80, v82
  v_add_f32 v84, v84, v86
  v_add_f32 v80, v80, v84
  v_mov_b32 v81, v80
  s_nop 1
  v_permlane32_swap_b32 v80, v81
  v_add_f32 v80, v80, v81
  v_mov_b32 v81, v80
  s_nop 1
  v_permlane16_swap_b32 v80, v81
  v_add_f32 v80, v80, v81
  s_nop 1
  v_add_f32_dpp v80, v80, v80 row_ror:8 row_mask:0xf bank_mask:0xf
  s_nop 1
  v_add_f32_dpp v80, v80, v80 row_ror:4 row_mask:0xf bank_mask:0xf
  s_nop 1
  v_add_f32_dpp v80, v80, v80 row_ror:2 row_mask:0xf bank_mask:0xf
  s_nop 1
  v_add_f32_dpp v80, v80, v80 row_ror:1 row_mask:0xf bank_mask:0xf
  v_cvt_pk_bf16_f32 v80, v80, v80
  v_lshlrev_b32 v80, 16, v80
  v_mul_f32 v80, 0xbfb8aa3b, v80
  v_exp_f32 v80, v80
  s_nop 0
  v_add_f32 v80, 1.0, v80
  v_rcp_f32 v80, v80
  s_nop 0
  v_cvt_pk_bf16_f32 v80, v80, v80
  v_lshlrev_b32 v80, 16, v80
  v_sub_f32 v81, 1.0, v80
  v_cvt_pk_bf16_f32 v81, v81, v81
  v_lshlrev_b32 v81, 16, v81
  v_mov_b32 v82, 1296
  ds_write_b64 v82, v[80:81]
  s_min_u32 s49, s33, 27
  s_lshl_b32 s37, s49, 12
  s_lshl_b32 s38, s32, 6
  s_add_u32 s38, s38, s37
  s_add_u32 s38, s38, 131072
  v_and_b32 v146, 3, v4
  v_lshlrev_b32 v146, 9, v146
  v_lshl_add_u32 v146, v3, 3, v146
  v_add_u32 v146, s38, v146
  s_lshl_b32 s37, s49, 7
  s_lshl_b32 s38, s32, 4
  s_add_u32 s37, s37, s38
  v_lshl_add_u32 v147, v3, 1, s37
  v_lshlrev_b32 v148, 1, v3
  v_add_u32 v148, 1280, v148
  s_lshl_b32 s37, s32, 17
  s_lshl_b32 s38, s33, 12
  s_add_u32 s37, s37, s38
  s_add_u32 s37, s37, 262144
  v_lshl_add_u32 v8, v2, 4, s37
  v_mov_b32 v152, 1308
  v_mov_b32 v153, 0
  ds_write_b32 v152, v153
  global_load_ushort v149, v147, s[18:19]
  s_barrier
  global_load_dwordx2 v[150:151], v146, s[30:31] sc1
  global_load_dwordx4 v[32:35], v8, s[30:31] offset:0 sc1
  global_load_dwordx4 v[36:39], v8, s[30:31] offset:1024 sc1
  global_load_dwordx4 v[40:43], v8, s[30:31] offset:2048 sc1
  global_load_dwordx4 v[44:47], v8, s[30:31] offset:3072 sc1
  s_barrier
  s_lshl_b32 s37, s33, 10
  s_add_u32 s37, s37, 32768
  v_lshl_add_u32 v142, v2, 4, s37
  v_lshlrev_b32 v143, 4, v3
  v_add_u32 v143, 1472, v143
  s_lshl_b32 s37, s32, 3
  s_lshl_b64 s[46:47], 0xff, s37
  v_lshlrev_b32 v84, 16, v145
  v_and_b32 v85, 0xffff0000, v145
  v_mul_f32 v84, v84, v81
  v_mul_f32 v85, v85, v81
  v_mov_b32 v12, 0
  v_mov_b32 v13, 0
  v_mov_b32 v14, 1
  ds_write_b96 v143, v[12:14]
  s_waitcnt lgkmcnt(0)
  s_barrier
  s_barrier
  s_mov_b32 s42, 0
  s_waitcnt vmcnt(4)
  s_branch LHchk
LHpoll:
  global_load_dwordx2 v[150:151], v146, s[30:31] sc1
  s_add_u32 s42, s42, 1
  s_waitcnt vmcnt(0)
LHchk:
  v_xor_b32 v9, v150, v151
  v_cmp_ne_u32 vcc, s36, v9
  s_cbranch_vccz LHgot
  s_cmp_lt_u32 s42, 1048576
  s_cbranch_scc1 LHpoll
LHgot:
  v_mov_b32 v8, v150
  s_cmp_lt_u32 s33, 28
  s_cselect_b32 s40, -1, 0
  v_add_f32_dpp v8, v8, v8 row_ror:8 row_mask:0xf bank_mask:0xf
  v_mov_b32 v9, v8
  s_nop 1
  v_permlane16_swap_b32 v8, v9
  v_add_f32 v8, v8, v9
  v_cvt_pk_bf16_f32 v8, v8, v8
  v_lshlrev_b32 v149, 16, v149
  v_lshlrev_b32 v8, 16, v8
  v_add_f32 v8, v8, v149
  v_cvt_pk_bf16_f32 v8, v8, v8
  v_lshlrev_b32 v8, 16, v8
  s_mov_b32 s41, 0xbdd2d3e8
  v_mov_b32 v10, 0xc0135761
  v_mul_f32 v9, v8, v8
  v_fma_f32 v9, v9, s41, v10
  v_mul_f32 v9, v9, v8
  v_exp_f32 v9, v9
  s_nop 0
  v_add_f32 v9, 1.0, v9
  v_rcp_f32 v9, v9
  s_nop 0
  v_mul_f32 v8, v8, v9
  s_nop 1
  v_mov_b32_dpp v9, v8 quad_perm:[1,0,3,2] row_mask:0xf bank_mask:0xf
  v_cvt_pk_bf16_f32 v8, v8, v9
  v_and_b32 v8, s40, v8
  s_mov_b64 exec, 0x55
  ds_write_b32 v148, v8
  s_mov_b64 exec, -1
  v_mov_b32 v153, 1
  ds_write_b32 v152, v153
  s_and_b32 s37, s33, 7
  s_cmp_lg_u32 s37, s32
  s_cbranch_scc1 LMnf
  global_load_dwordx3 v[12:14], v142, s[30:31] sc1
LMnf:
  s_barrier
  s_cbranch_scc1 LMend
  s_mov_b64 s[44:45], -1
  s_mov_b32 s42, 0
LGpoll:
  s_andn2_b64 exec, s[44:45], s[46:47]
  s_cbranch_execz LGs0
  global_load_dwordx3 v[12:14], v142, s[30:31] sc1
LGs0:
  s_and_b64 exec, s[44:45], s[46:47]
  ds_read_b96 v[12:14], v143
  s_mov_b64 exec, -1
  s_add_u32 s42, s42, 1
  s_waitcnt vmcnt(0) lgkmcnt(0)
  v_add3_u32 v16, v12, v13, s36
  v_mov_b32 v18, v12
  v_mov_b32 v19, v13
  v_cmp_ne_u32 s[44:45], v16, v14
  s_cmp_lg_u64 s[44:45], 0
  s_cbranch_scc0 LGgot
  s_cmp_lt_u32 s42, 1048576
  s_cbranch_scc1 LGpoll
LGgot:
  v_add_f32_dpp v18, v18, v18 row_ror:8 row_mask:0xf bank_mask:0xf
  v_add_f32_dpp v19, v19, v19 row_ror:8 row_mask:0xf bank_mask:0xf
  v_mov_b32 v10, v18
  v_mov_b32 v11, v19
  s_nop 0
  v_permlane32_swap_b32 v18, v10
  v_permlane32_swap_b32 v19, v11
  v_add_f32 v18, v18, v10
  v_add_f32 v19, v19, v11
  v_mov_b32 v10, v18
  v_mov_b32 v11, v19
  s_nop 0
  v_permlane16_swap_b32 v18, v10
  v_permlane16_swap_b32 v19, v11
  v_add_f32 v18, v18, v10
  v_add_f32 v19, v19, v11
  v_add_f32 v18, v18, v84
  v_add_f32 v19, v19, v85
  v_cvt_pk_bf16_f32 v8, v18, v19
  s_mov_b64 exec, 0xff
  global_store_dword v144, v8, s[26:27]
  s_cmp_lg_u32 s2, 0
  s_cbranch_scc1 LMend
  s_mov_b64 exec, 1
  v_mov_b32 v3, 0
  v_mov_b32 v9, s36
  global_store_dword v3, v9, s[30:31]
LMend:
  s_endpgm
LA:
  s_sub_u32 s43, s34, 2
  s_lshl_b32 s54, s32, 24
  s_lshl_b32 s38, s33, 15
  s_add_u32 s54, s54, s38
  s_lshl_b32 s38, s43, 13
  s_add_u32 s54, s54, s38
  s_add_u32 s54, s54, 15728640
  v_and_b32 v3, 15, v2
  v_lshrrev_b32 v4, 4, v2
  v_lshlrev_b32 v9, 4, v3
  s_lshl_b32 s37, s32, 19
  s_lshl_b32 s38, s33, 14
  s_add_u32 s37, s37, s38
  s_lshl_b32 s38, s33, 16
  s_lshl_b32 s39, s32, 13
  s_add_u32 s38, s38, s39
  s_lshl_b32 s39, s43, 8
  s_cmp_lt_u32 s33, 28
  s_cselect_b32 s38, s38, s37
  v_lshl_add_u32 v10, v4, 12, v9
  v_lshl_add_u32 v11, v4, 11, v9
  s_add_u32 s37, s37, s39
  s_add_u32 s38, s38, s39
  v_add_u32 v10, s37, v10
  v_add_u32 v11, s38, v11
  v_lshl_add_u32 v7, v4, 10, v9
  v_add_u32 v7, s54, v7
  v_add_u32 v8, 0x1000, v7
  v_lshlrev_b32 v5, 8, v3
  v_lshl_add_u32 v5, v4, 4, v5
  v_add_u32 v5, s54, v5
  v_add_u32 v6, 0x1000, v5
  s_cmp_lt_u32 s33, 28
  s_waitcnt lgkmcnt(0)
  s_cselect_b64 s[20:21], s[20:21], s[12:13]
  s_barrier
  global_load_dwordx4 v[64:67], v7, s[8:9] offset:0 nt
  global_load_dwordx4 v[68:71], v7, s[8:9] offset:256 nt
  global_load_dwordx4 v[72:75], v7, s[8:9] offset:512 nt
  global_load_dwordx4 v[76:79], v7, s[8:9] offset:768 nt
  global_load_dwordx4 v[80:83], v8, s[8:9] offset:0 nt
  global_load_dwordx4 v[84:87], v8, s[8:9] offset:256 nt
  global_load_dwordx4 v[88:91], v8, s[8:9] offset:512 nt
  global_load_dwordx4 v[92:95], v8, s[8:9] offset:768 nt
  s_load_dword s35, s[30:31], 0
  v_mov_b32 v168, 0
  v_mov_b32 v169, 0
  v_mov_b32 v170, 0
  v_mov_b32 v171, 0
  v_mov_b32 v172, 0
  v_mov_b32 v173, 0
  v_mov_b32 v174, 0
  v_mov_b32 v175, 0
  v_mov_b32 v176, 0
  v_mov_b32 v177, 0
  v_mov_b32 v178, 0
  v_mov_b32 v179, 0
  v_mov_b32 v180, 0
  global_load_dwordx4 v[32:35], v5, s[6:7] offset:0 nt
  v_mov_b32 v181, 0
  v_mov_b32 v182, 0
  v_mov_b32 v183, 0
  v_mov_b32 v204, 0x3f803f80
  v_mov_b32 v205, 0x3f803f80
  v_mov_b32 v206, 0x3f803f80
  v_mov_b32 v207, 0x3f803f80
  s_mov_b32 s44, 0x05040100
  s_mov_b32 s45, 0x07060302
  s_mov_b32 s46, 0x000f000f
  s_mov_b32 s47, 0x000f000f
  s_mov_b32 s48, 0x00f000f0
  s_mov_b32 s49, 0x00f000f0
  s_mov_b32 s50, 0x0f000f00
  global_load_dwordx4 v[48:51], v6, s[6:7] offset:0 nt
  s_mov_b32 s51, 0x0f000f00
  s_mov_b32 s52, 0xf000f000
  s_mov_b32 s53, 0xf000f000
  v_and_b32 v12, 3, v2
  v_mul_u32_u24 v12, 320, v12
  v_lshl_add_u32 v12, v4, 4, v12
  s_mul_i32 s37, s43, 2304
  s_add_u32 s37, s37, 2304
  v_mul_u32_u24 v13, 544, v4
  v_lshl_add_u32 v13, v3, 4, v13
  v_add_u32 v13, s37, v13
  s_lshl_b32 s37, s43, 3
  s_add_u32 s37, s37, 1344
  v_lshl_add_u32 v14, v2, 5, s37
  global_load_dwordx4 v[36:39], v5, s[6:7] offset:64 nt
  v_lshlrev_b32 v15, 3, v2
  v_add_u32 v15, 1600, v15
  v_cmp_gt_u32 vcc, 4, v2
  s_nop 1
  v_cndmask_b32 v14, v15, v14, vcc
  v_bfe_u32 v21, v2, 3, 2
  v_lshrrev_b32 v22, 5, v2
  s_lshl_b32 s37, s43, 1
  v_add_u32 v22, s37, v22
  v_and_b32 v23, 3, v2
  v_mul_u32_u24 v15, 544, v23
  v_lshl_add_u32 v15, v22, 5, v15
  v_bfe_u32 v23, v2, 2, 1
  v_lshl_add_u32 v15, v23, 4, v15
  global_load_dwordx4 v[52:55], v6, s[6:7] offset:64 nt
  v_lshl_add_u32 v15, v21, 2, v15
  v_add_u32 v15, 2304, v15
  v_lshlrev_b32 v16, 5, v21
  v_add_u32 v16, 1344, v16
  v_lshl_add_u32 v17, v21, 3, v22
  v_add_u32 v24, s33, v17
  v_and_b32 v24, 31, v24
  v_lshlrev_b32 v17, 12, v17
  v_lshl_add_u32 v17, v24, 7, v17
  v_and_b32 v23, 7, v2
  v_lshl_add_u32 v17, v23, 4, v17
  s_lshl_b32 s39, s32, 17
  s_add_u32 s39, s39, 262144
  v_add_u32 v17, s39, v17
  global_load_dwordx4 v[40:43], v5, s[6:7] offset:128 nt
  v_lshrrev_b32 v19, 1, v3
  v_and_b32 v23, 1, v3
  s_lshl_b32 s38, s43, 3
  s_add_u32 s38, s38, s33
  v_add_u32 v19, s38, v19
  v_and_b32 v19, 31, v19
  v_lshlrev_b32 v19, 7, v19
  v_lshl_add_u32 v19, v23, 6, v19
  v_lshl_add_u32 v19, v4, 4, v19
  s_lshl_b32 s38, s33, 12
  s_add_u32 s37, s38, s39
  v_add_u32 v19, s37, v19
  v_lshrrev_b32 v18, 1, v3
  v_lshlrev_b32 v18, 7, v18
  global_load_dwordx4 v[56:59], v6, s[6:7] offset:128 nt
  v_lshl_add_u32 v18, v23, 4, v18
  v_lshl_add_u32 v18, v4, 5, v18
  v_add_u32 v18, s37, v18
  v_mov_b32 v20, 1296
  v_lshlrev_b32 v9, 2, v4
  v_add_u32 v9, 1280, v9
  s_mov_b32 s54, 0x3fb8aa3b
  s_mov_b32 s60, 0x3db504f3
  s_mov_b32 s61, 0x3db504f3
  v_mov_b32 v232, 0
  v_mov_b32 v233, 0
  v_mov_b32 v234, 0
  v_mov_b32 v235, 0
  v_mov_b32 v236, 0
  global_load_dwordx4 v[44:47], v5, s[6:7] offset:192 nt
  v_mov_b32 v237, 0
  v_mov_b32 v238, 0
  v_mov_b32 v239, 0
  v_mov_b32 v240, 0
  v_mov_b32 v241, 0
  v_mov_b32 v242, 0
  v_mov_b32 v243, 0
  v_mov_b32 v244, 0
  v_mov_b32 v245, 0
  v_mov_b32 v246, 0
  v_mov_b32 v247, 0
  global_load_dwordx4 v[60:63], v6, s[6:7] offset:192 nt
  s_barrier
  s_barrier
  global_load_dwordx4 v[128:131], v10, s[12:13] offset:0 nt
  global_load_dwordx4 v[132:135], v10, s[12:13] offset:1024 nt
  global_load_dwordx4 v[136:139], v10, s[12:13] offset:2048 nt
  global_load_dwordx4 v[140:143], v10, s[12:13] offset:3072 nt
  global_load_dwordx4 v[144:147], v11, s[20:21] offset:0 nt
  global_load_dwordx4 v[148:151], v11, s[20:21] offset:1024 nt
  s_waitcnt vmcnt(20)
  v_perm_b32 v96, v68, v64, s44
  v_perm_b32 v100, v68, v64, s45
  v_perm_b32 v104, v69, v65, s44
  v_perm_b32 v108, v69, v65, s45
  v_perm_b32 v112, v70, v66, s44
  v_perm_b32 v116, v70, v66, s45
  v_perm_b32 v120, v71, v67, s44
  v_perm_b32 v124, v71, v67, s45
  s_waitcnt vmcnt(18)
  v_perm_b32 v97, v76, v72, s44
  v_perm_b32 v101, v76, v72, s45
  v_perm_b32 v105, v77, v73, s44
  v_perm_b32 v109, v77, v73, s45
  v_perm_b32 v113, v78, v74, s44
  v_perm_b32 v117, v78, v74, s45
  v_perm_b32 v121, v79, v75, s44
  v_perm_b32 v125, v79, v75, s45
  s_waitcnt vmcnt(16)
  v_perm_b32 v98, v84, v80, s44
  v_perm_b32 v102, v84, v80, s45
  v_perm_b32 v106, v85, v81, s44
  v_perm_b32 v110, v85, v81, s45
  v_perm_b32 v114, v86, v82, s44
  v_perm_b32 v118, v86, v82, s45
  v_perm_b32 v122, v87, v83, s44
  v_perm_b32 v126, v87, v83, s45
  s_waitcnt vmcnt(14)
  v_perm_b32 v99, v92, v88, s44
  v_perm_b32 v103, v92, v88, s45
  v_perm_b32 v107, v93, v89, s44
  v_perm_b32 v111, v93, v89, s45
  v_perm_b32 v115, v94, v90, s44
  v_perm_b32 v119, v94, v90, s45
  v_perm_b32 v123, v95, v91, s44
  v_perm_b32 v127, v95, v91, s45
  s_waitcnt lgkmcnt(0)
  s_and_b32 s36, s35, 0xfffffff8
  s_add_u32 s36, s36, 0x9e3779b8
  s_barrier
  ds_read_b128 v[152:155], v12 offset:0
  ds_read_b128 v[156:159], v12 offset:64
  ds_read_b128 v[160:163], v12 offset:128
  ds_read_b128 v[164:167], v12 offset:192
  ds_read_b96 v[28:30], v20
  s_waitcnt vmcnt(12) lgkmcnt(4)
  v_mfma_f32_16x16x32_bf16 v[184:187], v[32:35], v[152:155], 0
  v_mfma_f32_16x16x32_bf16 v[188:191], v[48:51], v[152:155], 0
  s_waitcnt vmcnt(10) lgkmcnt(3)
  v_mfma_f32_16x16x32_bf16 v[184:187], v[36:39], v[156:159], v[184:187]
  v_mfma_f32_16x16x32_bf16 v[188:191], v[52:55], v[156:159], v[188:191]
  s_waitcnt vmcnt(8) lgkmcnt(2)
  v_mfma_f32_16x16x32_bf16 v[184:187], v[40:43], v[160:163], v[184:187]
  v_mfma_f32_16x16x32_bf16 v[188:191], v[56:59], v[160:163], v[188:191]
  s_waitcnt vmcnt(6) lgkmcnt(1)
  v_mfma_f32_16x16x32_bf16 v[184:187], v[44:47], v[164:167], v[184:187]
  v_mfma_f32_16x16x32_bf16 v[188:191], v[60:63], v[164:167], v[188:191]
  s_waitcnt lgkmcnt(0)
  v_readfirstlane_b32 s57, v30
  s_cmp_eq_u32 s57, 0
  s_cselect_b32 s58, 8388608, 0
  s_add_u32 s58, s30, s58
  s_addc_u32 s59, s31, 0
  s_add_u32 s55, s36, 1540483472
  v_max3_f32 v21, v184, v185, v186
  v_max3_f32 v22, v187, v188, v189
  v_max3_f32 v21, v21, v190, v191
  v_max_f32 v21, v21, v22
  v_mov_b32 v22, v21
  v_cvt_pk_bf16_f32 v152, v184, v185
  v_cvt_pk_bf16_f32 v153, v186, v187
  v_permlane32_swap_b32 v21, v22
  v_max_f32 v21, v21, v22
  v_mov_b32 v22, v21
  v_cvt_pk_bf16_f32 v154, v188, v189
  v_cvt_pk_bf16_f32 v155, v190, v191
  v_permlane16_swap_b32 v21, v22
  v_max_f32 v21, v21, v22
  v_cvt_pk_bf16_f32 v21, v21, v21
  v_lshlrev_b32 v184, 16, v152
  v_and_b32 v185, 0xffff0000, v152
  v_lshlrev_b32 v186, 16, v153
  v_and_b32 v187, 0xffff0000, v153
  v_lshlrev_b32 v188, 16, v154
  v_and_b32 v189, 0xffff0000, v154
  v_lshlrev_b32 v190, 16, v155
  v_and_b32 v191, 0xffff0000, v155
  v_lshlrev_b32 v21, 16, v21
  v_pk_mul_f32 v[184:185], v[184:185], s[60:61]
  v_pk_mul_f32 v[186:187], v[186:187], s[60:61]
  v_pk_mul_f32 v[188:189], v[188:189], s[60:61]
  v_pk_mul_f32 v[190:191], v[190:191], s[60:61]
  v_mul_f32 v21, s60, v21
  v_cvt_pk_bf16_f32 v152, v184, v185
  v_cvt_pk_bf16_f32 v153, v186, v187
  v_cvt_pk_bf16_f32 v154, v188, v189
  v_cvt_pk_bf16_f32 v155, v190, v191
  v_cvt_pk_bf16_f32 v21, v21, v21
  v_lshlrev_b32 v21, 16, v21
  v_mul_f32 v21, s54, v21
  v_lshlrev_b32 v184, 16, v152
  v_and_b32 v185, 0xffff0000, v152
  v_fma_f32 v184, v184, s54, -v21
  v_fma_f32 v185, v185, s54, -v21
  v_exp_f32 v184, v184
  v_exp_f32 v185, v185
  v_lshlrev_b32 v186, 16, v153
  v_and_b32 v187, 0xffff0000, v153
  v_fma_f32 v186, v186, s54, -v21
  v_fma_f32 v187, v187, s54, -v21
  v_exp_f32 v186, v186
  v_exp_f32 v187, v187
  v_lshlrev_b32 v188, 16, v154
  v_and_b32 v189, 0xffff0000, v154
  v_fma_f32 v188, v188, s54, -v21
  v_fma_f32 v189, v189, s54, -v21
  v_exp_f32 v188, v188
  v_exp_f32 v189, v189
  v_lshlrev_b32 v190, 16, v155
  v_and_b32 v191, 0xffff0000, v155
  v_fma_f32 v190, v190, s54, -v21
  v_fma_f32 v191, v191, s54, -v21
  v_exp_f32 v190, v190
  v_exp_f32 v191, v191
  s_mov_b64 exec, s[46:47]
  v_cvt_pk_bf16_f32 v168, v184, v185
  v_cvt_pk_bf16_f32 v169, v186, v187
  v_cvt_pk_bf16_f32 v170, v188, v189
  v_cvt_pk_bf16_f32 v171, v190, v191
  s_mov_b64 exec, -1
  s_nop 0
  v_mfma_f32_16x16x32_bf16 v[192:195], v[168:171], v[96:99], 0
  v_mfma_f32_16x16x32_bf16 v[196:199], v[168:171], v[100:103], 0
  v_mfma_f32_16x16x32_bf16 v[200:203], v[204:207], v[168:171], 0
  s_mov_b64 exec, s[48:49]
  v_cvt_pk_bf16_f32 v172, v184, v185
  v_cvt_pk_bf16_f32 v173, v186, v187
  v_cvt_pk_bf16_f32 v174, v188, v189
  v_cvt_pk_bf16_f32 v175, v190, v191
  s_mov_b64 exec, -1
  s_nop 0
  v_mfma_f32_16x16x32_bf16 v[192:195], v[172:175], v[104:107], v[192:195]
  v_mfma_f32_16x16x32_bf16 v[196:199], v[172:175], v[108:111], v[196:199]
  s_mov_b64 exec, s[50:51]
  v_cvt_pk_bf16_f32 v176, v184, v185
  v_cvt_pk_bf16_f32 v177, v186, v187
  v_cvt_pk_bf16_f32 v178, v188, v189
  v_cvt_pk_bf16_f32 v179, v190, v191
  s_mov_b64 exec, -1
  s_nop 0
  v_mfma_f32_16x16x32_bf16 v[192:195], v[176:179], v[112:115], v[192:195]
  v_mfma_f32_16x16x32_bf16 v[196:199], v[176:179], v[116:119], v[196:199]
  s_mov_b64 exec, s[52:53]
  v_cvt_pk_bf16_f32 v180, v184, v185
  v_cvt_pk_bf16_f32 v181, v186, v187
  v_cvt_pk_bf16_f32 v182, v188, v189
  v_cvt_pk_bf16_f32 v183, v190, v191
  s_mov_b64 exec, -1
  s_nop 0
  v_mfma_f32_16x16x32_bf16 v[192:195], v[180:183], v[120:123], v[192:195]
  v_mfma_f32_16x16x32_bf16 v[196:199], v[180:183], v[124:127], v[196:199]
  ds_write2_b32 v14, v21, v200 offset0:0 offset1:1
  s_nop 5
  ds_write_b128 v13, v[192:195]
  ds_write_b128 v13, v[196:199] offset:256
  s_waitcnt lgkmcnt(0)
  s_barrier
  ds_read_b128 v[40:43], v16
  ds_read_b128 v[44:47], v16 offset:16
  ds_read2st64_b32 v[32:33], v15 offset0:0 offset1:1
  ds_read2st64_b32 v[34:35], v15 offset0:9 offset1:10
  ds_read2st64_b32 v[36:37], v15 offset0:18 offset1:19
  ds_read2st64_b32 v[38:39], v15 offset0:27 offset1:28
  s_waitcnt lgkmcnt(4)
  v_max3_f32 v21, v40, v42, v44
  v_max_f32 v21, v21, v46
  v_sub_f32 v40, v40, v21
  v_sub_f32 v42, v42, v21
  v_exp_f32 v40, v40
  v_sub_f32 v44, v44, v21
  v_exp_f32 v42, v42
  v_sub_f32 v46, v46, v21
  v_exp_f32 v44, v44
  v_exp_f32 v46, v46
  v_mul_f32 v22, v40, v41
  v_fmac_f32 v22, v42, v43
  v_fmac_f32 v22, v44, v45
  v_fmac_f32 v22, v46, v47
  v_rcp_f32 v23, v22
  v_log_f32 v22, v22
  s_waitcnt lgkmcnt(0)
  v_mul_f32 v48, v40, v32
  v_mul_f32 v49, v40, v33
  v_fmac_f32 v48, v42, v34
  v_fmac_f32 v49, v42, v35
  v_fmac_f32 v48, v44, v36
  v_fmac_f32 v49, v44, v37
  v_fmac_f32 v48, v46, v38
  v_fmac_f32 v49, v46, v39
  v_add_f32 v50, v21, v22
  v_mul_f32 v48, v48, v23
  v_mul_f32 v49, v49, v23
  v_add_u32 v51, s36, v50
  v_add3_u32 v51, v48, v49, v51
  s_cmp_eq_u32 s57, 0
  s_cbranch_scc1 Lslow0
  global_store_dwordx4 v17, v[48:51], s[58:59] nt
Lsd0:
  global_load_dwordx4 v[96:99], v18, s[58:59] offset:0 sc1
  global_load_dwordx4 v[100:103], v18, s[58:59] offset:1024 sc1
  global_load_dwordx4 v[104:107], v18, s[58:59] offset:2048 sc1
  global_load_dwordx4 v[108:111], v18, s[58:59] offset:3072 sc1
  v_mov_b32 v25, 1308
  ds_read_b32 v25, v25
  ds_read_b32 v24, v9
  s_waitcnt vmcnt(5)
  v_perm_b32 v208, v132, v128, s44
  v_perm_b32 v209, v132, v128, s45
  v_perm_b32 v210, v133, v129, s44
  v_perm_b32 v211, v133, v129, s45
  v_perm_b32 v212, v134, v130, s44
  v_perm_b32 v213, v134, v130, s45
  v_perm_b32 v214, v135, v131, s44
  v_perm_b32 v215, v135, v131, s45
  v_perm_b32 v216, v140, v136, s44
  v_perm_b32 v217, v140, v136, s45
  v_perm_b32 v218, v141, v137, s44
  v_perm_b32 v219, v141, v137, s45
  v_perm_b32 v220, v142, v138, s44
  v_perm_b32 v221, v142, v138, s45
  v_perm_b32 v222, v143, v139, s44
  v_perm_b32 v223, v143, v139, s45
  v_perm_b32 v224, v148, v144, s44
  v_perm_b32 v225, v148, v144, s45
  v_perm_b32 v226, v149, v145, s44
  v_perm_b32 v227, v149, v145, s45
  v_perm_b32 v228, v150, v146, s44
  v_perm_b32 v229, v150, v146, s45
  v_perm_b32 v230, v151, v147, s44
  v_perm_b32 v231, v151, v147, s45
  s_waitcnt lgkmcnt(0)
  v_readfirstlane_b32 s56, v25
  s_mov_b64 s[46:47], -1
  s_mov_b64 s[48:49], -1
  s_mov_b64 s[50:51], -1
  s_mov_b64 s[52:53], -1
  s_mov_b32 s42, 0
  s_cmp_eq_u32 s56, 0
  s_cbranch_scc1 LBnoh
  v_dot2c_f32_bf16 v232, v24, v224
  v_dot2c_f32_bf16 v233, v24, v225
  v_dot2c_f32_bf16 v234, v24, v226
  v_dot2c_f32_bf16 v235, v24, v227
  v_dot2c_f32_bf16 v236, v24, v228
  v_dot2c_f32_bf16 v237, v24, v229
  v_dot2c_f32_bf16 v238, v24, v230
  v_dot2c_f32_bf16 v239, v24, v231
  s_nop 2
  v_permlane32_swap_b32 v232, v236
  v_permlane32_swap_b32 v233, v237
  v_permlane32_swap_b32 v234, v238
  v_permlane32_swap_b32 v235, v239
  v_add_f32 v232, v232, v236
  v_add_f32 v233, v233, v237
  v_add_f32 v234, v234, v238
  v_add_f32 v235, v235, v239
  s_nop 0
  v_permlane16_swap_b32 v232, v234
  v_permlane16_swap_b32 v233, v235
  v_add_f32 v232, v232, v234
  v_add_f32 v233, v233, v235
  v_mul_f32 v232, v232, v29
  v_mul_f32 v233, v233, v29
LBnoh:
  s_branch LBchk
LBpoll:
  s_mov_b64 exec, s[46:47]
  s_cbranch_execz LBs0
  global_load_dwordx4 v[96:99], v18, s[58:59] offset:0 sc1
LBs0:
  s_mov_b64 exec, s[48:49]
  s_cbranch_execz LBs1
  global_load_dwordx4 v[100:103], v18, s[58:59] offset:1024 sc1
LBs1:
  s_mov_b64 exec, s[50:51]
  s_cbranch_execz LBs2
  global_load_dwordx4 v[104:107], v18, s[58:59] offset:2048 sc1
LBs2:
  s_mov_b64 exec, s[52:53]
  s_cbranch_execz LBs3
  global_load_dwordx4 v[108:111], v18, s[58:59] offset:3072 sc1
LBs3:
  s_mov_b64 exec, -1
  s_add_u32 s42, s42, 1
  s_cmp_eq_u32 s56, 0
  s_cbranch_scc1 Lhtry
LBchk:
  s_waitcnt vmcnt(0)
  v_add3_u32 v112, v96, v97, v98
  v_add3_u32 v113, v100, v101, v102
  v_add3_u32 v114, v104, v105, v106
  v_add3_u32 v115, v108, v109, v110
  v_max3_f32 v21, v98, v102, v106
  v_sub_u32 v112, v99, v112
  v_sub_u32 v113, v103, v113
  v_sub_u32 v114, v107, v114
  v_sub_u32 v115, v111, v115
  v_max_f32 v21, v21, v110
  v_cmp_ne_u32 s[46:47], s36, v112
  v_cmp_ne_u32 s[48:49], s36, v113
  v_cmp_ne_u32 s[50:51], s36, v114
  v_cmp_ne_u32 s[52:53], s36, v115
  v_max_f32_dpp v21, v21, v21 row_ror:2 row_mask:0xf bank_mask:0xf
  s_or_b64 s[40:41], s[46:47], s[48:49]
  s_or_b64 vcc, s[50:51], s[52:53]
  v_max_f32_dpp v21, v21, v21 row_ror:4 row_mask:0xf bank_mask:0xf
  s_or_b64 s[40:41], s[40:41], vcc
  s_cbranch_scc0 LBgot
  s_cmp_lt_u32 s42, 1048576
  s_cbranch_scc1 LBpoll
LBgot:
  v_max_f32_dpp v21, v21, v21 row_ror:8 row_mask:0xf bank_mask:0xf
  v_sub_f32 v112, v98, v21
  v_sub_f32 v113, v102, v21
  v_exp_f32 v112, v112
  v_sub_f32 v114, v106, v21
  v_exp_f32 v113, v113
  v_sub_f32 v115, v110, v21
  v_exp_f32 v114, v114
  v_exp_f32 v115, v115
  v_mul_f32 v22, v112, v96
  v_mul_f32 v23, v112, v97
  v_add_f32 v21, v112, v113
  v_fmac_f32 v22, v113, v100
  v_fmac_f32 v23, v113, v101
  v_add_f32 v21, v21, v114
  v_fmac_f32 v22, v114, v104
  v_fmac_f32 v23, v114, v105
  v_add_f32 v21, v21, v115
  v_fmac_f32 v22, v115, v108
  v_fmac_f32 v23, v115, v109
  v_add_f32_dpp v21, v21, v21 row_ror:2 row_mask:0xf bank_mask:0xf
  v_add_f32_dpp v22, v22, v22 row_ror:2 row_mask:0xf bank_mask:0xf
  v_add_f32_dpp v23, v23, v23 row_ror:2 row_mask:0xf bank_mask:0xf
  v_add_f32_dpp v21, v21, v21 row_ror:4 row_mask:0xf bank_mask:0xf
  v_add_f32_dpp v22, v22, v22 row_ror:4 row_mask:0xf bank_mask:0xf
  v_add_f32_dpp v23, v23, v23 row_ror:4 row_mask:0xf bank_mask:0xf
  v_add_f32_dpp v21, v21, v21 row_ror:8 row_mask:0xf bank_mask:0xf
  v_add_f32_dpp v22, v22, v22 row_ror:8 row_mask:0xf bank_mask:0xf
  v_add_f32_dpp v23, v23, v23 row_ror:8 row_mask:0xf bank_mask:0xf
  v_rcp_f32 v21, v21
  s_nop 0
  v_mul_f32 v22, v22, v21
  v_mul_f32 v23, v23, v21
  v_cvt_pk_bf16_f32 v22, v22, v23
  s_nop 1
  v_dot2c_f32_bf16_dpp v240, v22, v208 quad_perm:[0,0,0,0] row_mask:0xf bank_mask:0xf
  v_dot2c_f32_bf16_dpp v241, v22, v209 quad_perm:[0,0,0,0] row_mask:0xf bank_mask:0xf
  v_dot2c_f32_bf16_dpp v242, v22, v210 quad_perm:[0,0,0,0] row_mask:0xf bank_mask:0xf
  v_dot2c_f32_bf16_dpp v243, v22, v211 quad_perm:[0,0,0,0] row_mask:0xf bank_mask:0xf
  v_dot2c_f32_bf16_dpp v244, v22, v212 quad_perm:[0,0,0,0] row_mask:0xf bank_mask:0xf
  v_dot2c_f32_bf16_dpp v245, v22, v213 quad_perm:[0,0,0,0] row_mask:0xf bank_mask:0xf
  v_dot2c_f32_bf16_dpp v246, v22, v214 quad_perm:[0,0,0,0] row_mask:0xf bank_mask:0xf
  v_dot2c_f32_bf16_dpp v247, v22, v215 quad_perm:[0,0,0,0] row_mask:0xf bank_mask:0xf
  v_dot2c_f32_bf16_dpp v240, v22, v216 quad_perm:[1,1,1,1] row_mask:0xf bank_mask:0xf
  v_dot2c_f32_bf16_dpp v241, v22, v217 quad_perm:[1,1,1,1] row_mask:0xf bank_mask:0xf
  v_dot2c_f32_bf16_dpp v242, v22, v218 quad_perm:[1,1,1,1] row_mask:0xf bank_mask:0xf
  v_dot2c_f32_bf16_dpp v243, v22, v219 quad_perm:[1,1,1,1] row_mask:0xf bank_mask:0xf
  v_dot2c_f32_bf16_dpp v244, v22, v220 quad_perm:[1,1,1,1] row_mask:0xf bank_mask:0xf
  v_dot2c_f32_bf16_dpp v245, v22, v221 quad_perm:[1,1,1,1] row_mask:0xf bank_mask:0xf
  v_dot2c_f32_bf16_dpp v246, v22, v222 quad_perm:[1,1,1,1] row_mask:0xf bank_mask:0xf
  v_dot2c_f32_bf16_dpp v247, v22, v223 quad_perm:[1,1,1,1] row_mask:0xf bank_mask:0xf
  s_nop 2
  v_permlane32_swap_b32 v240, v244
  v_permlane32_swap_b32 v241, v245
  v_permlane32_swap_b32 v242, v246
  v_permlane32_swap_b32 v243, v247
  v_add_f32 v240, v240, v244
  v_add_f32 v241, v241, v245
  v_add_f32 v242, v242, v246
  v_add_f32 v243, v243, v247
  s_nop 0
  v_permlane16_swap_b32 v240, v242
  v_permlane16_swap_b32 v241, v243
  v_add_f32 v240, v240, v242
  v_add_f32 v241, v241, v243
  s_cmp_eq_u32 s56, 0
  s_cbranch_scc1 Lhlate
Lhback:
  v_fma_f32 v24, v240, v28, v232
  v_fma_f32 v25, v241, v28, v233
  v_add3_u32 v26, v24, v25, s55
  s_barrier
  s_cmp_eq_u32 s57, 0
  s_cbranch_scc1 Lslow1
  global_store_dwordx4 v19, v[24:27], s[58:59] nt
Lsd1:
  s_endpgm
Lhtry:
  v_mov_b32 v25, 1308
  ds_read_b32 v25, v25
  ds_read_b32 v24, v9
  s_waitcnt lgkmcnt(0)
  v_readfirstlane_b32 s56, v25
  s_cmp_eq_u32 s56, 0
  s_cbranch_scc1 LBchk
  v_dot2c_f32_bf16 v232, v24, v224
  v_dot2c_f32_bf16 v233, v24, v225
  v_dot2c_f32_bf16 v234, v24, v226
  v_dot2c_f32_bf16 v235, v24, v227
  v_dot2c_f32_bf16 v236, v24, v228
  v_dot2c_f32_bf16 v237, v24, v229
  v_dot2c_f32_bf16 v238, v24, v230
  v_dot2c_f32_bf16 v239, v24, v231
  s_nop 2
  v_permlane32_swap_b32 v232, v236
  v_permlane32_swap_b32 v233, v237
  v_permlane32_swap_b32 v234, v238
  v_permlane32_swap_b32 v235, v239
  v_add_f32 v232, v232, v236
  v_add_f32 v233, v233, v237
  v_add_f32 v234, v234, v238
  v_add_f32 v235, v235, v239
  s_nop 0
  v_permlane16_swap_b32 v232, v234
  v_permlane16_swap_b32 v233, v235
  v_add_f32 v232, v232, v234
  v_add_f32 v233, v233, v235
  v_mul_f32 v232, v232, v29
  v_mul_f32 v233, v233, v29
  s_branch LBchk
Lhlate:
  s_mov_b32 s42, 0
Lhl2:
  v_mov_b32 v25, 1308
  ds_read_b32 v25, v25
  ds_read_b32 v24, v9
  s_add_u32 s42, s42, 1
  s_waitcnt lgkmcnt(0)
  v_readfirstlane_b32 s56, v25
  s_cmp_ge_u32 s42, 1048576
  s_cbranch_scc1 Lhl3
  s_cmp_eq_u32 s56, 0
  s_cbranch_scc1 Lhl2
Lhl3:
  v_dot2c_f32_bf16 v232, v24, v224
  v_dot2c_f32_bf16 v233, v24, v225
  v_dot2c_f32_bf16 v234, v24, v226
  v_dot2c_f32_bf16 v235, v24, v227
  v_dot2c_f32_bf16 v236, v24, v228
  v_dot2c_f32_bf16 v237, v24, v229
  v_dot2c_f32_bf16 v238, v24, v230
  v_dot2c_f32_bf16 v239, v24, v231
  s_nop 2
  v_permlane32_swap_b32 v232, v236
  v_permlane32_swap_b32 v233, v237
  v_permlane32_swap_b32 v234, v238
  v_permlane32_swap_b32 v235, v239
  v_add_f32 v232, v232, v236
  v_add_f32 v233, v233, v237
  v_add_f32 v234, v234, v238
  v_add_f32 v235, v235, v239
  s_nop 0
  v_permlane16_swap_b32 v232, v234
  v_permlane16_swap_b32 v233, v235
  v_add_f32 v232, v232, v234
  v_add_f32 v233, v233, v235
  v_mul_f32 v232, v232, v29
  v_mul_f32 v233, v233, v29
  s_branch Lhback
LQsb:
  s_mov_b32 exec_lo, 0xff
  s_mov_b32 exec_hi, 0xff
  global_store_dwordx4 v7, v[128:131], s[30:31] sc1
  s_mov_b64 exec, -1
  s_branch LQsbr
Lslow0:
  global_store_dwordx4 v17, v[48:51], s[58:59] sc1
  s_branch Lsd0
Lslow1:
  global_store_dwordx4 v19, v[24:27], s[58:59] sc1
  s_branch Lsd1
Lend:
  s_endpgm
.section .rodata,"a"
.p2align 6
.amdhsa_kernel gated_mix__sliding_block_cached__dense_activation_gelu__decode_kernel
  .amdhsa_next_free_vgpr 248
  .amdhsa_next_free_sgpr 100
  .amdhsa_accum_offset 248
  .amdhsa_group_segment_fixed_size 0
  .amdhsa_kernarg_size 112
  .amdhsa_user_sgpr_count 2
  .amdhsa_user_sgpr_kernarg_segment_ptr 1
  .amdhsa_system_sgpr_workgroup_id_x 1
.end_amdhsa_kernel
```
